```python
import torch

def _softmax(x, axis=-1):
    return torch.softmax(x, dim=axis)
def _gelu(x):
    return torch.nn.functional.gelu(x, approximate="tanh")
def _silu(x):
    return torch.nn.functional.silu(x)
def _sigmoid(x):
    return torch.sigmoid(x)
def _layernorm(x, axis=-1, eps=1e-5):
    m = x.mean(dim=axis, keepdim=True)
    v = x.var(dim=axis, keepdim=True, unbiased=False)
    return (x - m) / torch.sqrt(v + eps)
def _scatter_add(tgt, idx, src, axis=0):
    return tgt.clone().index_add_(axis, idx, src)
def _segment_sum(src, seg, n):
    out = torch.zeros((n,) + src.shape[1:], dtype=src.dtype)
    return out.index_add_(0, seg, src)
def _pad(x, pw):
    flat = tuple(v for pair in reversed(pw) for v in pair)
    return torch.nn.functional.pad(x, flat)

kernel_name = 'standalone__low_rank_proj_linformer__sampling'

def setup_inputs():

    _w = (lambda a: (lambda t: t.to(torch.bfloat16) if t.is_floating_point() else t)(torch.as_tensor(a)))
    B, H, Sq, Skv, Dh, R = 16, 32, 8, 2048, 128, 16
    return {
        "q": _w((lambda *s: torch.randn(*s, dtype=torch.bfloat16) * 0.8)(B, H, Sq, Dh)),
        "k": _w((lambda *s: torch.randn(*s, dtype=torch.bfloat16) * 0.8)(B, H, Skv, Dh)),
        "v": _w((lambda *s: torch.randn(*s, dtype=torch.bfloat16) * 0.05)(B, H, Skv, Dh)),
        "e_proj": _w((lambda *s: torch.randn(*s, dtype=torch.bfloat16) * 0.8)(R, Skv) * (Skv ** -0.5)),
        "f_proj": _w((lambda *s: torch.randn(*s, dtype=torch.bfloat16) * 0.05)(R, Skv) * (Skv ** -0.5)),
    }

def reference(q, k, v, e_proj, f_proj):
    B, H, Sq, Dh = q.shape
    kp = torch.einsum("rn,bhnd->bhrd", e_proj, k)
    vp = torch.einsum("rn,bhnd->bhrd", f_proj, v)
    scores = torch.einsum("bhqd,bhrd->bhqr", q, kp) * (Dh ** -0.5)
    p = _softmax(scores, axis=-1)
    o = torch.einsum("bhqr,bhrd->bhqd", p, vp)
    return o
```

```asm
; @launch grid=(256,1,1) block=(256,1,1) lds=153856
.amdgcn_target "amdgcn-amd-amdhsa--gfx950"
.text
.globl standalone__low_rank_proj_linformer__sampling_kernel
.p2align 12
.p2align 8
.type standalone__low_rank_proj_linformer__sampling_kernel,@function
standalone__low_rank_proj_linformer__sampling_kernel:
    s_load_dwordx16 s[64:79], s[0:1], 0
    v_readfirstlane_b32 s3, v0
    s_cmp_ge_u32 s2, 256
    s_cbranch_scc1 L_done
    v_and_b32 v4, 15, v0
    v_bfe_u32 v5, v0, 4, 2
    v_mov_b32 v7, 147456
    s_bfe_u32 s28, s2, 0x10000
    s_lshl_b32 s28, s28, 5
    s_bfe_u32 s29, s2, 0x20001
    s_lshl_b32 s29, s29, 2
    s_or_b32 s28, s28, s29
    s_bfe_u32 s29, s2, 0x20003
    s_or_b32 s28, s28, s29
    s_bfe_u32 s29, s2, 0x10005
    s_lshl_b32 s29, s29, 4
    s_or_b32 s28, s28, s29
    s_and_b32 s29, s2, 192
    s_or_b32 s28, s28, s29
    s_mov_b32 s19, 0x00020000
    s_mov_b32 s23, 0x00020000
    s_cmp_eq_u32 s3, 0
    s_cbranch_scc1 L_loader
    s_memrealtime s[40:41]
    v_mov_b32 v8, 0
    v_mov_b32 v9, 0
    v_mov_b32 v10, 0x400008
    v_mov_b32 v11, 0
    ds_write_b32 v7, v8
    ds_write_b128 v7, v[8:11] offset:16
    ds_write_b64 v7, v[8:9] offset:32
    v_bfe_u32 v13, v0, 3, 3
    s_and_b32 s30, s3, 128
    v_lshl_add_u32 v56, v13, 8, s30
    v_and_b32 v13, 7, v0
    v_lshl_add_u32 v56, v13, 4, v56
    s_lshl_b32 s30, s30, 4
    s_add_u32 m0, s30, 149760
    s_lshl_b32 s27, s28, 12
    s_movk_i32 s18, 4096
    v_and_b32 v14, 31, v0
    s_bfe_u32 s29, s2, 0x40003
    s_lshl_b32 s29, s29, 7
    v_lshl_add_u32 v14, v14, 11, s29
    s_cmp_lg_u32 s3, 192
    s_waitcnt lgkmcnt(0)
    s_cbranch_scc1 L_meetc
    s_bitcmp1_b32 s2, 7
    s_cselect_b64 s[20:21], s[72:73], s[70:71]
    s_mov_b32 exec_hi, 0
    global_load_dword v15, v14, s[20:21]
    s_cmp_ge_u32 s2, 8
    s_cbranch_scc1 L_nostart
    s_mul_i32 s29, s2, 4352
    s_add_u32 s29, s29, 1013760
    v_and_b32 v18, 31, v0
    v_mov_b32 v16, s40
    v_lshl_add_u32 v18, v18, 2, s29
    global_store_dword v18, v16, s[78:79] sc0 sc1
L_nostart:
    s_barrier
    s_branch L_balance
L_meetc:
    s_add_u32 s16, s64, s27
    s_addc_u32 s17, s65, 0
    buffer_load_dwordx4 v56, s[16:19], 0 offen nt lds
    s_add_u32 m0, m0, 1024
    s_movk_i32 s29, 2048
    buffer_load_dwordx4 v56, s[16:19], s29 offen nt lds
    s_barrier
    s_branch L_consumer
L_loader:
    v_lshlrev_b32 v6, 1, v5
    v_xor_b32 v6, v6, v4
    v_lshlrev_b32 v6, 4, v6
    v_lshl_add_u32 v6, v5, 8, v6
    s_bfe_u32 s24, s2, 0x10007
    s_lshl_b32 s27, s24, 11
    s_add_u32 s30, s27, 2048
    s_sub_u32 s26, 2048, s27
    v_add_u32 v16, s30, v6
    v_xor_b32 v6, 0x80, v6
    v_add_u32 v17, s26, v6
    v_add_u32 v18, 8192, v16
    v_add_u32 v19, 8192, v17
    s_lshl_b32 s28, s28, 20
    s_sub_u32 s28, s28, 2048
    s_subb_u32 s27, 0, 0
    s_mov_b32 s18, 0x100800
    s_mov_b32 m0, 0
    v_lshrrev_b32 v4, 2, v0
    v_and_b32 v5, 2, v5
    v_xor_b32 v5, v5, v0
    v_xor_b32 v5, s24, v5
    v_lshlrev_b32 v32, 12, v4
    v_and_b32 v6, 1, v5
    v_lshl_add_u32 v32, v6, 4, v32
    v_bfe_u32 v6, v5, 1, 1
    v_lshl_add_u32 v32, v6, 6, v32
    s_mov_b32 s22, 65536
    s_waitcnt lgkmcnt(0)
    s_add_u32 s16, s66, s28
    s_addc_u32 s17, s67, s27
    buffer_load_dwordx4 v16, s[16:19], 0 offen nt lds
    buffer_load_dwordx4 v16, s[16:19], 0 offen offset:1024 nt lds
    buffer_load_dwordx4 v17, s[16:19], 0 offen offset:2048 nt lds
    buffer_load_dwordx4 v17, s[16:19], 0 offen offset:3072 nt lds
    s_add_u32 m0, m0, 4096
    s_mov_b64 s[20:21], s[70:71]
    v_add_u32 v20, 32768, v16
    v_add_u32 v21, 32768, v17
    buffer_load_dwordx4 v18, s[16:19], 0 offen nt lds
    buffer_load_dwordx4 v18, s[16:19], 0 offen offset:1024 nt lds
    buffer_load_dwordx4 v19, s[16:19], 0 offen offset:2048 nt lds
    buffer_load_dwordx4 v19, s[16:19], 0 offen offset:3072 nt lds
    s_add_u32 m0, m0, 4096
    v_add_u32 v22, 32768, v18
    buffer_load_dwordx4 v32, s[20:23], 0 offen lds
    s_add_u32 m0, m0, 1024
    v_add_u32 v23, 32768, v19
    v_add_u32 v33, 256, v32
    buffer_load_dwordx4 v20, s[16:19], 0 offen nt lds
    buffer_load_dwordx4 v20, s[16:19], 0 offen offset:1024 nt lds
    buffer_load_dwordx4 v21, s[16:19], 0 offen offset:2048 nt lds
    buffer_load_dwordx4 v21, s[16:19], 0 offen offset:3072 nt lds
    s_add_u32 m0, m0, 4096
    v_add_u32 v24, 65536, v16
    v_add_u32 v25, 65536, v17
    buffer_load_dwordx4 v22, s[16:19], 0 offen nt lds
    buffer_load_dwordx4 v22, s[16:19], 0 offen offset:1024 nt lds
    buffer_load_dwordx4 v23, s[16:19], 0 offen offset:2048 nt lds
    buffer_load_dwordx4 v23, s[16:19], 0 offen offset:3072 nt lds
    s_add_u32 m0, m0, 4096
    v_add_u32 v26, 65536, v18
    buffer_load_dwordx4 v33, s[20:23], 0 offen lds
    s_add_u32 m0, m0, 1024
    v_add_u32 v27, 65536, v19
    v_add_u32 v34, 512, v32
    v_add_u32 v28, 98304, v16
    v_add_u32 v29, 98304, v17
    v_add_u32 v30, 98304, v18
    v_add_u32 v31, 98304, v19
    v_add_u32 v35, 768, v32
    s_mov_b32 s31, 0
    s_mov_b32 s32, 0
    s_mov_b32 s33, 0
    s_mov_b32 s36, 0x400008
    s_mov_b32 s37, 0xc0000f
    s_mov_b32 s38, 0xffff8001
    s_add_u32 s24, s68, s28
    s_addc_u32 s25, s69, s27
    v_mov_b32 v12, 256
    s_barrier
    s_branch L_p16
L_body:
L_p0:
    s_getreg_b32 s40, hwreg(HW_REG_IB_STS)
    s_and_b32 s40, s40, s37
    s_cmp_ge_u32 s40, s36
    s_cbranch_scc1 L_p0
    buffer_load_dwordx4 v16, s[16:19], s32 offen nt lds
L_p1:
    s_getreg_b32 s40, hwreg(HW_REG_IB_STS)
    s_and_b32 s40, s40, s37
    s_cmp_ge_u32 s40, s36
    s_cbranch_scc1 L_p1
    buffer_load_dwordx4 v16, s[16:19], s32 offen offset:1024 nt lds
L_p2:
    s_getreg_b32 s40, hwreg(HW_REG_IB_STS)
    s_and_b32 s40, s40, s37
    s_cmp_ge_u32 s40, s36
    s_cbranch_scc1 L_p2
    buffer_load_dwordx4 v17, s[16:19], s32 offen offset:2048 nt lds
L_p3:
    s_getreg_b32 s40, hwreg(HW_REG_IB_STS)
    s_and_b32 s40, s40, s37
    s_cmp_ge_u32 s40, s36
    s_cbranch_scc1 L_p3
    buffer_load_dwordx4 v17, s[16:19], s32 offen offset:3072 nt lds
    s_add_u32 m0, m0, 4096
    v_add_u32 v12, 48, v12
    v_add_u32 v11, s40, v12
    ds_write_b32 v7, v11
    ds_read_b32 v10, v7 offset:24
L_p4:
    s_getreg_b32 s40, hwreg(HW_REG_IB_STS)
    s_and_b32 s40, s40, s37
    s_cmp_ge_u32 s40, s36
    s_cbranch_scc1 L_p4
    buffer_load_dwordx4 v18, s[16:19], s32 offen nt lds
L_p5:
    s_getreg_b32 s40, hwreg(HW_REG_IB_STS)
    s_and_b32 s40, s40, s37
    s_cmp_ge_u32 s40, s36
    s_cbranch_scc1 L_p5
    buffer_load_dwordx4 v18, s[16:19], s32 offen offset:1024 nt lds
L_p6:
    s_getreg_b32 s40, hwreg(HW_REG_IB_STS)
    s_and_b32 s40, s40, s37
    s_cmp_ge_u32 s40, s36
    s_cbranch_scc1 L_p6
    buffer_load_dwordx4 v19, s[16:19], s32 offen offset:2048 nt lds
L_p7:
    s_getreg_b32 s40, hwreg(HW_REG_IB_STS)
    s_and_b32 s40, s40, s37
    s_cmp_ge_u32 s40, s36
    s_cbranch_scc1 L_p7
    buffer_load_dwordx4 v19, s[16:19], s32 offen offset:3072 nt lds
    s_add_u32 m0, m0, 4096
    v_add_u32 v12, 64, v12
    buffer_load_dwordx4 v32, s[20:23], s33 offen lds
    s_add_u32 m0, m0, 1024
    s_waitcnt lgkmcnt(0)
    v_readfirstlane_b32 s36, v10
    v_add_u32 v11, s40, v12
    ds_write_b32 v7, v11
L_p8:
    s_getreg_b32 s40, hwreg(HW_REG_IB_STS)
    s_and_b32 s40, s40, s37
    s_cmp_ge_u32 s40, s36
    s_cbranch_scc1 L_p8
    buffer_load_dwordx4 v20, s[16:19], s32 offen nt lds
L_p9:
    s_getreg_b32 s40, hwreg(HW_REG_IB_STS)
    s_and_b32 s40, s40, s37
    s_cmp_ge_u32 s40, s36
    s_cbranch_scc1 L_p9
    buffer_load_dwordx4 v20, s[16:19], s32 offen offset:1024 nt lds
L_p10:
    s_getreg_b32 s40, hwreg(HW_REG_IB_STS)
    s_and_b32 s40, s40, s37
    s_cmp_ge_u32 s40, s36
    s_cbranch_scc1 L_p10
    buffer_load_dwordx4 v21, s[16:19], s32 offen offset:2048 nt lds
L_p11:
    s_getreg_b32 s40, hwreg(HW_REG_IB_STS)
    s_and_b32 s40, s40, s37
    s_cmp_ge_u32 s40, s36
    s_cbranch_scc1 L_p11
    buffer_load_dwordx4 v21, s[16:19], s32 offen offset:3072 nt lds
    s_add_u32 m0, m0, 4096
    v_add_u32 v12, 80, v12
    v_add_u32 v11, s40, v12
    ds_write_b32 v7, v11
    ds_read_b32 v10, v7 offset:24
L_p12:
    s_getreg_b32 s40, hwreg(HW_REG_IB_STS)
    s_and_b32 s40, s40, s37
    s_cmp_ge_u32 s40, s36
    s_cbranch_scc1 L_p12
    buffer_load_dwordx4 v22, s[16:19], s32 offen nt lds
L_p13:
    s_getreg_b32 s40, hwreg(HW_REG_IB_STS)
    s_and_b32 s40, s40, s37
    s_cmp_ge_u32 s40, s36
    s_cbranch_scc1 L_p13
    buffer_load_dwordx4 v22, s[16:19], s32 offen offset:1024 nt lds
L_p14:
    s_getreg_b32 s40, hwreg(HW_REG_IB_STS)
    s_and_b32 s40, s40, s37
    s_cmp_ge_u32 s40, s36
    s_cbranch_scc1 L_p14
    buffer_load_dwordx4 v23, s[16:19], s32 offen offset:2048 nt lds
L_p15:
    s_getreg_b32 s40, hwreg(HW_REG_IB_STS)
    s_and_b32 s40, s40, s37
    s_cmp_ge_u32 s40, s36
    s_cbranch_scc1 L_p15
    buffer_load_dwordx4 v23, s[16:19], s32 offen offset:3072 nt lds
    s_add_u32 m0, m0, 4096
    v_add_u32 v12, 64, v12
    buffer_load_dwordx4 v33, s[20:23], s33 offen lds
    s_add_u32 m0, m0, 1024
    s_waitcnt lgkmcnt(0)
    v_readfirstlane_b32 s36, v10
    v_add_u32 v11, s40, v12
    ds_write_b32 v7, v11
L_p16:
    s_getreg_b32 s40, hwreg(HW_REG_IB_STS)
    s_and_b32 s40, s40, s37
    s_cmp_ge_u32 s40, s36
    s_cbranch_scc1 L_p16
    buffer_load_dwordx4 v24, s[16:19], s32 offen nt lds
L_p17:
    s_getreg_b32 s40, hwreg(HW_REG_IB_STS)
    s_and_b32 s40, s40, s37
    s_cmp_ge_u32 s40, s36
    s_cbranch_scc1 L_p17
    buffer_load_dwordx4 v24, s[16:19], s32 offen offset:1024 nt lds
L_p18:
    s_getreg_b32 s40, hwreg(HW_REG_IB_STS)
    s_and_b32 s40, s40, s37
    s_cmp_ge_u32 s40, s36
    s_cbranch_scc1 L_p18
    buffer_load_dwordx4 v25, s[16:19], s32 offen offset:2048 nt lds
L_p19:
    s_getreg_b32 s40, hwreg(HW_REG_IB_STS)
    s_and_b32 s40, s40, s37
    s_cmp_ge_u32 s40, s36
    s_cbranch_scc1 L_p19
    buffer_load_dwordx4 v25, s[16:19], s32 offen offset:3072 nt lds
    s_add_u32 m0, m0, 4096
    v_add_u32 v12, 80, v12
    v_add_u32 v11, s40, v12
    ds_write_b32 v7, v11
    ds_read_b32 v10, v7 offset:24
L_p20:
    s_getreg_b32 s40, hwreg(HW_REG_IB_STS)
    s_and_b32 s40, s40, s37
    s_cmp_ge_u32 s40, s36
    s_cbranch_scc1 L_p20
    buffer_load_dwordx4 v26, s[16:19], s32 offen nt lds
L_p21:
    s_getreg_b32 s40, hwreg(HW_REG_IB_STS)
    s_and_b32 s40, s40, s37
    s_cmp_ge_u32 s40, s36
    s_cbranch_scc1 L_p21
    buffer_load_dwordx4 v26, s[16:19], s32 offen offset:1024 nt lds
L_p22:
    s_getreg_b32 s40, hwreg(HW_REG_IB_STS)
    s_and_b32 s40, s40, s37
    s_cmp_ge_u32 s40, s36
    s_cbranch_scc1 L_p22
    buffer_load_dwordx4 v27, s[16:19], s32 offen offset:2048 nt lds
L_p23:
    s_getreg_b32 s40, hwreg(HW_REG_IB_STS)
    s_and_b32 s40, s40, s37
    s_cmp_ge_u32 s40, s36
    s_cbranch_scc1 L_p23
    buffer_load_dwordx4 v27, s[16:19], s32 offen offset:3072 nt lds
    s_add_u32 m0, m0, 4096
    v_add_u32 v12, 64, v12
    buffer_load_dwordx4 v34, s[20:23], s33 offen lds
    s_add_u32 m0, m0, 1024
    s_waitcnt lgkmcnt(0)
    v_readfirstlane_b32 s36, v10
    v_add_u32 v11, s40, v12
    ds_write_b32 v7, v11
L_p24:
    s_getreg_b32 s40, hwreg(HW_REG_IB_STS)
    s_and_b32 s40, s40, s37
    s_cmp_ge_u32 s40, s36
    s_cbranch_scc1 L_p24
    buffer_load_dwordx4 v28, s[16:19], s32 offen nt lds
L_p25:
    s_getreg_b32 s40, hwreg(HW_REG_IB_STS)
    s_and_b32 s40, s40, s37
    s_cmp_ge_u32 s40, s36
    s_cbranch_scc1 L_p25
    buffer_load_dwordx4 v28, s[16:19], s32 offen offset:1024 nt lds
L_p26:
    s_getreg_b32 s40, hwreg(HW_REG_IB_STS)
    s_and_b32 s40, s40, s37
    s_cmp_ge_u32 s40, s36
    s_cbranch_scc1 L_p26
    buffer_load_dwordx4 v29, s[16:19], s32 offen offset:2048 nt lds
L_p27:
    s_getreg_b32 s40, hwreg(HW_REG_IB_STS)
    s_and_b32 s40, s40, s37
    s_cmp_ge_u32 s40, s36
    s_cbranch_scc1 L_p27
    buffer_load_dwordx4 v29, s[16:19], s32 offen offset:3072 nt lds
    s_add_u32 m0, m0, 4096
    v_add_u32 v12, 80, v12
    v_add_u32 v11, s40, v12
    ds_write_b32 v7, v11
    ds_read_b128 v[36:39], v7 offset:16
L_p28:
    s_getreg_b32 s40, hwreg(HW_REG_IB_STS)
    s_and_b32 s40, s40, s37
    s_cmp_ge_u32 s40, s36
    s_cbranch_scc1 L_p28
    buffer_load_dwordx4 v30, s[16:19], s32 offen nt lds
L_p29:
    s_getreg_b32 s40, hwreg(HW_REG_IB_STS)
    s_and_b32 s40, s40, s37
    s_cmp_ge_u32 s40, s36
    s_cbranch_scc1 L_p29
    buffer_load_dwordx4 v30, s[16:19], s32 offen offset:1024 nt lds
L_p30:
    s_getreg_b32 s40, hwreg(HW_REG_IB_STS)
    s_and_b32 s40, s40, s37
    s_cmp_ge_u32 s40, s36
    s_cbranch_scc1 L_p30
    buffer_load_dwordx4 v31, s[16:19], s32 offen offset:2048 nt lds
L_p31:
    s_getreg_b32 s40, hwreg(HW_REG_IB_STS)
    s_and_b32 s40, s40, s37
    s_cmp_ge_u32 s40, s36
    s_cbranch_scc1 L_p31
    buffer_load_dwordx4 v31, s[16:19], s32 offen offset:3072 nt lds
    s_add_u32 m0, m0, 4096
    v_add_u32 v12, 64, v12
    buffer_load_dwordx4 v35, s[20:23], s33 offen lds
    s_add_u32 m0, m0, 1024
    v_add_u32 v11, s40, v12
    ds_write_b32 v7, v11
    v_add_u32 v12, 32, v12
    s_add_u32 s31, s31, 4
    s_cmp_eq_u32 s31, 256
    s_cbranch_scc1 L_drain
    s_cmp_eq_u32 m0, 147456
    s_cselect_b32 m0, 0, m0
    s_bitcmp1_b32 s31, 7
    s_cselect_b64 s[16:17], s[24:25], s[16:17]
    s_cselect_b64 s[20:21], s[72:73], s[20:21]
    s_bfe_u32 s30, s31, 0x40002
    s_cselect_b32 s38, s38, 0xffff8000
L_chkfree:
    s_waitcnt lgkmcnt(0)
    v_min_u32 v36, v36, v37
    v_readfirstlane_b32 s36, v38
    v_readfirstlane_b32 s29, v36
    v_readfirstlane_b32 s39, v39
    s_add_u32 s29, s29, 12
    s_cmp_gt_u32 s31, s29
    s_cbranch_scc1 L_full
    s_add_u32 s30, s30, s39
    s_ff0_i32_b32 s29, s38
    s_bitcmp1_b32 s38, s30
    s_cselect_b32 s30, s29, s30
    s_bitset1_b32 s38, s30
    s_bitcmp1_b32 s30, 0
    s_cselect_b32 s29, 14, 0
    s_xor_b32 s30, s30, s29
    s_bfe_u32 s29, s30, 0x10000
    s_lshl_b32 s32, s29, 12
    s_bfe_u32 s29, s30, 0x20001
    s_lshl_b32 s29, s29, 17
    s_or_b32 s32, s32, s29
    s_bfe_u32 s29, s30, 0x10003
    s_lshl_b32 s29, s29, 14
    s_or_b32 s32, s32, s29
    s_lshr_b32 s33, s32, 7
    s_bfe_u32 s29, s31, 0x10006
    s_lshl_b32 s29, s29, 19
    s_or_b32 s32, s32, s29
    s_branch L_body
L_full:
    s_getreg_b32 s40, hwreg(HW_REG_IB_STS)
    s_and_b32 s40, s40, s37
    v_add_u32 v11, s40, v12
    ds_write_b32 v7, v11
    ds_read_b128 v[36:39], v7 offset:16
    s_branch L_chkfree
L_drain:
    v_mov_b32 v11, 36288
    s_waitcnt vmcnt(36)
    ds_write_b32 v7, v11
    v_mov_b32 v11, 36432
    s_waitcnt vmcnt(27)
    ds_write_b32 v7, v11
    v_mov_b32 v11, 36576
    s_waitcnt vmcnt(18)
    ds_write_b32 v7, v11
    v_mov_b32 v11, 36720
    s_waitcnt vmcnt(9)
    ds_write_b32 v7, v11
    s_waitcnt vmcnt(0)
    s_barrier
    s_endpgm
L_balance:
    v_and_b32 v9, 7, v0
    v_mul_u32_u24 v9, 4352, v9
    v_add_u32 v9, 1048576, v9
    s_mul_i32 s58, s2, 4352
    s_add_u32 s58, s58, 1048576
    s_mov_b32 s31, 18
    s_mov_b32 s33, 2
    s_mov_b32 s52, 0
    s_mov_b32 s53, 214
    s_mov_b32 s55, 0
    s_mov_b32 s57, 0
    s_mov_b32 exec_lo, 0xffff
    s_sub_u32 s40, s40, 300
    v_subrev_u32 v13, 34816, v9
    s_memrealtime s[44:45]
    global_load_dword v12, v13, s[78:79] sc0 sc1
    s_waitcnt vmcnt(0) lgkmcnt(0)
    s_sub_u32 s54, s44, s40
    s_sub_u32 s54, s54, 40
    v_subrev_u32 v12, s40, v12
    v_min_u32 v12, s54, v12
    s_nop 1
    v_add_u32_dpp v12, v12, v12 row_ror:1 row_mask:0xf bank_mask:0xf
    s_nop 1
    v_add_u32_dpp v12, v12, v12 row_ror:2 row_mask:0xf bank_mask:0xf
    s_nop 1
    v_add_u32_dpp v12, v12, v12 row_ror:4 row_mask:0xf bank_mask:0xf
    s_nop 1
    v_readfirstlane_b32 s38, v12
    s_lshr_b32 s38, s38, 3
    s_sub_u32 s38, 300, s38
    s_sub_u32 s39, s38, 32
    s_ashr_i32 s39, s39, 1
    s_add_u32 s39, s39, 32
    s_min_i32 s38, s38, s39
    s_add_u32 s38, s38, 196
    s_ashr_i32 s38, s38, 3
    s_max_i32 s38, s38, 21
    s_min_i32 s38, s38, 38
    s_lshl_b32 s39, s38, 18
    s_or_b32 s38, s38, s39
    s_and_b32 s38, s38, 0xc0000f
    v_mov_b32 v10, s38
    v_mov_b32 v11, s57
    ds_write_b64 v7, v[10:11] offset:24
L_step:
    ds_read_b32 v8, v7
    s_waitcnt lgkmcnt(0)
    v_readfirstlane_b32 s28, v8
    s_lshr_b32 s29, s28, 18
    s_and_b32 s30, s28, 15
    s_or_b32 s29, s29, s30
    s_bfe_u32 s28, s28, 0xe0004
    s_sub_u32 s28, s28, s29
    s_cmp_lt_u32 s28, s31
    s_cbranch_scc1 L_step
    s_memrealtime s[44:45]
    s_and_b32 s34, s33, 7
    s_cmp_ge_u32 s33, 248
    s_cselect_b32 s34, -1, s34
    s_waitcnt lgkmcnt(0)
    s_sub_u32 s54, s44, s40
    s_cmp_lg_u32 s34, 2
    s_cbranch_scc1 L_nonotes
    s_cmp_lt_u32 s33, 8
    s_cbranch_scc1 L_nonotes
    s_waitcnt vmcnt(0)
    v_subrev_u32 v12, s40, v12
    v_min_u32 v12, s55, v12
    s_nop 1
    v_add_u32_dpp v12, v12, v12 row_ror:1 row_mask:0xf bank_mask:0xf
    s_nop 1
    v_add_u32_dpp v12, v12, v12 row_ror:2 row_mask:0xf bank_mask:0xf
    s_nop 1
    v_add_u32_dpp v12, v12, v12 row_ror:4 row_mask:0xf bank_mask:0xf
    s_nop 1
    v_readfirstlane_b32 s38, v12
    s_lshr_b32 s38, s38, 3
    s_sub_u32 s35, s59, s38
    s_sub_u32 s39, s38, s52
    s_mov_b32 s52, s38
    s_sub_u32 s56, s33, 10
    s_max_u32 s56, s56, 2
    s_sub_u32 s38, s39, s53
    s_max_i32 s38, s38, -12
    s_min_i32 s38, s38, 12
    s_add_u32 s38, s38, 4
    s_ashr_i32 s38, s38, 3
    s_add_u32 s38, s38, s53
    s_cmp_lt_u32 s33, 24
    s_cselect_b32 s53, s53, s38
L_nonotes:
    s_cmp_lt_u32 s33, 10
    s_cbranch_scc1 L_noset
    s_sub_u32 s38, s33, s56
    s_mul_i32 s38, s38, s53
    s_lshr_b32 s38, s38, 3
    s_add_u32 s38, s38, s52
    s_sub_u32 s38, s54, s38
    s_mul_i32 s39, s57, 107
    s_min_i32 s36, s35, s38
    s_sub_u32 s36, s36, s39
    s_sub_u32 s39, s38, s39
    s_cmp_gt_i32 s36, 120
    s_addc_u32 s57, s57, 0
    s_cmp_lt_i32 s39, -65
    s_subb_u32 s57, s57, 0
    s_max_i32 s57, s57, 0
    s_min_i32 s57, s57, 15
    s_sub_u32 s39, s38, 32
    s_ashr_i32 s39, s39, 1
    s_add_u32 s39, s39, 32
    s_min_i32 s38, s38, s39
    s_add_u32 s38, s38, 196
    s_ashr_i32 s38, s38, 3
    s_max_i32 s38, s38, 21
    s_min_i32 s38, s38, 38
    s_lshl_b32 s39, s38, 18
    s_or_b32 s38, s38, s39
    s_and_b32 s38, s38, 0xc0000f
    v_mov_b32 v10, s38
    v_mov_b32 v11, s57
    ds_write_b64 v7, v[10:11] offset:24
L_noset:
    s_cmp_eq_u32 s33, 2
    s_cselect_b32 s34, 0, s34
    s_cmp_lg_u32 s34, 0
    s_cbranch_scc1 L_next
    s_mov_b32 s59, s55
    s_mov_b32 s55, s54
    s_cmp_ge_u32 s2, 8
    s_cbranch_scc1 L_nowrite
    v_mov_b32 v16, s44
    v_mov_b32 v17, s44
    v_lshl_add_u32 v18, v4, 3, s58
    global_store_dwordx2 v18, v[16:17], s[78:79] sc0 sc1
    s_add_u32 s58, s58, 34816
L_nowrite:
    s_cmp_eq_u32 s33, 2
    s_cbranch_scc1 L_next
    global_load_dword v12, v9, s[78:79] sc0 sc1
    v_add_u32 v9, 34816, v9
L_next:
    s_add_u32 s31, s31, 18
    s_add_u32 s33, s33, 2
    s_cmp_lt_u32 s33, 252
    s_cbranch_scc1 L_step
    s_endpgm
L_consumer:
    v_and_b32 v0, 63, v0
    s_add_u32 s29, s30, 149760
    v_lshl_add_u32 v64, v13, 7, s29
    v_lshl_add_u32 v64, v5, 3, v64
    s_lshr_b32 s3, s3, 7
    s_lshl_b32 s29, s3, 7
    v_lshl_add_u32 v19, v13, 8, s29
    v_lshrrev_b32 v13, 3, v4
    v_lshl_add_u32 v19, v13, 6, v19
    v_and_b32 v13, 1, v5
    v_lshl_add_u32 v19, v13, 5, v19
    v_lshrrev_b32 v6, 1, v5
    v_lshl_add_u32 v19, v6, 4, v19
    v_cmp_lt_u32 vcc, 7, v4
    v_bfe_u32 v6, v0, 2, 2
    v_lshl_add_u32 v12, v5, 3, v6
    v_lshl_add_u32 v6, v13, 2, v6
    s_lshl_b32 s29, s3, 2
    v_xor_b32 v6, s29, v6
    v_lshlrev_b32 v6, 5, v6
    v_lshl_add_u32 v6, v12, 8, v6
    v_and_b32 v13, 3, v0
    v_lshl_add_u32 v8, v13, 3, v6
    v_xor_b32 v9, 32, v8
    v_xor_b32 v10, 64, v8
    v_xor_b32 v11, 96, v8
    v_lshrrev_b32 v13, 2, v4
    v_and_b32 v13, 2, v13
    v_xor_b32 v13, v13, v5
    v_lshl_add_u32 v13, v4, 2, v13
    v_lshlrev_b32 v12, 4, v13
    v_add_u32 v12, 8192, v12
    v_add_u32 v3, s29, v7
    v_xor_b32 v2, 4, v3
    s_add_u32 s16, s74, s27
    s_addc_u32 s17, s75, 0
    s_add_u32 s20, s16, 2048
    s_addc_u32 s21, s17, 0
    s_movk_i32 s18, 2048
    s_movk_i32 s22, 2048
    s_mov_b32 s31, 0
    s_mov_b32 s32, 9
    s_mov_b32 s33, 0
    s_mov_b32 s34, 0
    s_branch L_headk
L_fold:
    s_cmp_eq_u32 s28, 60
    s_nop 3
    v_cvt_f64_f32 v[76:77], v40
    v_mov_b32 v40, 0
    v_add_f64 v[92:93], v[92:93], v[76:77]
    v_cvt_f64_f32 v[78:79], v41
    v_mov_b32 v41, 0
    v_add_f64 v[94:95], v[94:95], v[78:79]
    v_cvt_f64_f32 v[80:81], v42
    v_mov_b32 v42, 0
    v_add_f64 v[96:97], v[96:97], v[80:81]
    v_cvt_f64_f32 v[82:83], v43
    v_mov_b32 v43, 0
    v_add_f64 v[98:99], v[98:99], v[82:83]
    v_cvt_f64_f32 v[76:77], v44
    v_mov_b32 v44, 0
    v_add_f64 v[100:101], v[100:101], v[76:77]
    v_cvt_f64_f32 v[78:79], v45
    v_mov_b32 v45, 0
    v_add_f64 v[102:103], v[102:103], v[78:79]
    v_cvt_f64_f32 v[80:81], v46
    v_mov_b32 v46, 0
    v_add_f64 v[104:105], v[104:105], v[80:81]
    v_cvt_f64_f32 v[82:83], v47
    v_mov_b32 v47, 0
    v_add_f64 v[106:107], v[106:107], v[82:83]
    v_cvt_f64_f32 v[76:77], v48
    v_mov_b32 v48, 0
    v_add_f64 v[108:109], v[108:109], v[76:77]
    v_cvt_f64_f32 v[78:79], v49
    v_mov_b32 v49, 0
    v_add_f64 v[110:111], v[110:111], v[78:79]
    v_cvt_f64_f32 v[80:81], v50
    v_mov_b32 v50, 0
    v_add_f64 v[112:113], v[112:113], v[80:81]
    v_cvt_f64_f32 v[82:83], v51
    v_mov_b32 v51, 0
    v_add_f64 v[114:115], v[114:115], v[82:83]
    v_cvt_f64_f32 v[76:77], v52
    v_mov_b32 v52, 0
    v_add_f64 v[116:117], v[116:117], v[76:77]
    v_cvt_f64_f32 v[78:79], v53
    v_mov_b32 v53, 0
    v_add_f64 v[118:119], v[118:119], v[78:79]
    v_cvt_f64_f32 v[80:81], v54
    v_mov_b32 v54, 0
    v_add_f64 v[120:121], v[120:121], v[80:81]
    v_cvt_f64_f32 v[82:83], v55
    v_mov_b32 v55, 0
    v_add_f64 v[122:123], v[122:123], v[82:83]
    s_cbranch_scc0 L_folded
    v_cvt_f32_f64 v40, v[92:93]
    v_cvt_f32_f64 v41, v[94:95]
    v_cvt_f32_f64 v42, v[96:97]
    v_cvt_f32_f64 v43, v[98:99]
    v_cvt_f32_f64 v44, v[100:101]
    v_cvt_f32_f64 v45, v[102:103]
    v_cvt_f32_f64 v46, v[104:105]
    v_cvt_f32_f64 v47, v[106:107]
    v_cvt_f32_f64 v48, v[108:109]
    v_cvt_f32_f64 v49, v[110:111]
    v_cvt_f32_f64 v50, v[112:113]
    v_cvt_f32_f64 v51, v[114:115]
    v_cvt_f32_f64 v52, v[116:117]
    v_cvt_f32_f64 v53, v[118:119]
    v_cvt_f32_f64 v54, v[120:121]
    v_cvt_f32_f64 v55, v[122:123]
L_folded:
    s_bitcmp0_b32 s31, 7
    s_cbranch_scc1 L_k
    s_cmp_lg_u32 s31, 248
    s_cbranch_scc1 L_v
    buffer_store_dwordx4 v[72:75], v19, s[16:19], 0 offen
    s_branch L_v
L_headk:
    v_mov_b64 v[40:41], 0
    v_mov_b64 v[42:43], 0
    v_mov_b64 v[44:45], 0
    v_mov_b64 v[46:47], 0
    v_mov_b64 v[48:49], 0
    v_mov_b64 v[50:51], 0
    v_mov_b64 v[52:53], 0
    v_mov_b64 v[54:55], 0
    v_mov_b64 v[92:93], 0
    v_mov_b64 v[94:95], 0
    v_mov_b64 v[96:97], 0
    v_mov_b64 v[98:99], 0
    v_mov_b64 v[100:101], 0
    v_mov_b64 v[102:103], 0
    v_mov_b64 v[104:105], 0
    v_mov_b64 v[106:107], 0
    v_mov_b64 v[108:109], 0
    v_mov_b64 v[110:111], 0
    v_mov_b64 v[112:113], 0
    v_mov_b64 v[114:115], 0
    v_mov_b64 v[116:117], 0
    v_mov_b64 v[118:119], 0
    v_mov_b64 v[120:121], 0
    v_mov_b64 v[122:123], 0
L_k:
    v_add_u32 v14, s34, v8
    v_add_u32 v15, s34, v9
    v_add_u32 v16, s34, v10
    v_add_u32 v17, s34, v11
    v_add_u32 v18, s34, v12
    s_add_u32 s31, s31, 1
    v_mov_b32 v13, s31
    s_cmp_ge_u32 s33, s32
    s_cbranch_scc1 L_k_go
L_k_poll:
    ds_read_b32 v6, v7
    s_waitcnt lgkmcnt(0)
    v_readfirstlane_b32 s33, v6
    s_lshr_b32 s29, s33, 18
    s_and_b32 s30, s33, 15
    s_or_b32 s29, s29, s30
    s_bfe_u32 s33, s33, 0xe0004
    s_sub_u32 s33, s33, s29
    s_cmp_lt_u32 s33, s32
    s_cbranch_scc1 L_k_poll
L_k_go:
    ds_read_b128 v[20:23], v18
    ds_read_b64_tr_b16 v[24:25], v14
    ds_read_b64_tr_b16 v[26:27], v14 offset:1024
    ds_read_b64_tr_b16 v[28:29], v15
    ds_read_b64_tr_b16 v[30:31], v15 offset:1024
    ds_read_b64_tr_b16 v[32:33], v16
    ds_read_b64_tr_b16 v[34:35], v16 offset:1024
    ds_read_b64_tr_b16 v[36:37], v17
    ds_read_b64_tr_b16 v[38:39], v17 offset:1024
    ds_write_b32 v3, v13 offset:16
    s_add_u32 s32, s32, 9
    s_add_u32 s34, s34, 9216
    s_cmp_eq_u32 s34, 147456
    s_cselect_b32 s34, 0, s34
    s_and_b32 s28, s31, 3
    s_waitcnt lgkmcnt(7)
    v_mfma_f32_16x16x32_bf16 v[40:43], v[24:27], v[20:23], v[40:43]
    s_waitcnt lgkmcnt(5)
    v_mfma_f32_16x16x32_bf16 v[44:47], v[28:31], v[20:23], v[44:47]
    s_waitcnt lgkmcnt(3)
    v_mfma_f32_16x16x32_bf16 v[48:51], v[32:35], v[20:23], v[48:51]
    s_waitcnt lgkmcnt(1)
    v_mfma_f32_16x16x32_bf16 v[52:55], v[36:39], v[20:23], v[52:55]
    s_cbranch_scc1 L_k
    s_and_b32 s28, s31, 63
    s_cbranch_scc1 L_fold
    s_waitcnt vmcnt(0)
    ds_read_b64 v[56:57], v64 offset:0
    ds_read_b64 v[58:59], v64 offset:32
    ds_read_b64 v[60:61], v64 offset:64
    ds_read_b64 v[62:63], v64 offset:96
    v_add_u32 v64, 1024, v64
    v_cvt_pk_bf16_f32 v76, v40, v41
    v_cvt_pk_bf16_f32 v77, v42, v43
    v_cvt_pk_bf16_f32 v78, v44, v45
    v_cvt_pk_bf16_f32 v79, v46, v47
    v_cvt_pk_bf16_f32 v80, v48, v49
    v_cvt_pk_bf16_f32 v81, v50, v51
    v_cvt_pk_bf16_f32 v82, v52, v53
    v_cvt_pk_bf16_f32 v83, v54, v55
    s_lshl_b32 s28, s3, 10
    s_add_u32 s28, s28, 139520
    s_waitcnt lgkmcnt(0)
    v_mfma_f32_16x16x32_bf16 v[84:87], v[76:79], v[56:59], 0
    v_mfma_f32_16x16x32_bf16 v[84:87], v[80:83], v[60:63], v[84:87]
    v_add_u32 v14, s28, v12
    v_xor_b32 v15, 16, v0
    v_xor_b32 v16, 32, v0
    v_lshlrev_b32 v15, 2, v15
    v_lshlrev_b32 v16, 2, v16
    s_xor_b32 s29, s3, 1
    s_lshl_b32 s29, s29, 10
    s_add_u32 s29, s29, 139520
    v_add_u32 v17, s29, v12
    ds_write_b128 v14, v[84:87]
    ds_write_b32 v3, v13 offset:32
L_scpoll:
    ds_read_b32 v6, v2 offset:32
    s_waitcnt lgkmcnt(0)
    v_readfirstlane_b32 s28, v6
    s_cmp_lt_u32 s28, s31
    s_cbranch_scc1 L_scpoll
    ds_read_b128 v[76:79], v17
    s_waitcnt lgkmcnt(0)
    v_add_f32 v76, v76, v84
    v_add_f32 v77, v77, v85
    v_add_f32 v78, v78, v86
    v_add_f32 v79, v79, v87
    v_cvt_pk_bf16_f32 v80, v76, v77
    v_cvt_pk_bf16_f32 v81, v78, v79
    v_lshlrev_b32 v76, 16, v80
    v_and_b32 v77, 0xffff0000, v80
    v_lshlrev_b32 v78, 16, v81
    v_and_b32 v79, 0xffff0000, v81
    v_mul_f32 v76, 0x3db504f3, v76
    v_mul_f32 v77, 0x3db504f3, v77
    v_mul_f32 v78, 0x3db504f3, v78
    v_mul_f32 v79, 0x3db504f3, v79
    v_cvt_pk_bf16_f32 v80, v76, v77
    v_cvt_pk_bf16_f32 v81, v78, v79
    v_lshlrev_b32 v76, 16, v80
    v_and_b32 v77, 0xffff0000, v80
    v_lshlrev_b32 v78, 16, v81
    v_and_b32 v79, 0xffff0000, v81
    v_max_f32 v80, v76, v77
    v_max3_f32 v80, v78, v79, v80
    ds_bpermute_b32 v81, v15, v80
    s_waitcnt lgkmcnt(0)
    v_max_f32 v80, v80, v81
    ds_bpermute_b32 v81, v16, v80
    s_waitcnt lgkmcnt(0)
    v_max_f32 v80, v80, v81
    v_sub_f32 v76, v76, v80
    v_sub_f32 v77, v77, v80
    v_sub_f32 v78, v78, v80
    v_sub_f32 v79, v79, v80
    v_mul_f32 v76, 0x3fb8aa3b, v76
    v_mul_f32 v77, 0x3fb8aa3b, v77
    v_mul_f32 v78, 0x3fb8aa3b, v78
    v_mul_f32 v79, 0x3fb8aa3b, v79
    v_exp_f32 v76, v76
    v_exp_f32 v77, v77
    v_exp_f32 v78, v78
    v_exp_f32 v79, v79
    s_nop 0
    v_add_f32 v80, v76, v77
    v_add_f32 v81, v78, v79
    v_add_f32 v80, v80, v81
    ds_bpermute_b32 v81, v15, v80
    s_waitcnt lgkmcnt(0)
    v_add_f32 v80, v80, v81
    ds_bpermute_b32 v81, v16, v80
    s_waitcnt lgkmcnt(0)
    v_add_f32 v80, v80, v81
    v_rcp_f32 v80, v80
    v_mov_b64 v[66:67], v[68:69]
    v_mul_f32 v76, v76, v80
    v_mul_f32 v77, v77, v80
    v_mul_f32 v78, v78, v80
    v_mul_f32 v79, v79, v80
    v_cvt_pk_bf16_f32 v68, v76, v77
    v_cvt_pk_bf16_f32 v69, v78, v79
    s_cmp_eq_u32 s31, 64
    s_cbranch_scc1 L_headk
L_headv:
    v_mov_b64 v[40:41], 0
    v_mov_b64 v[42:43], 0
    v_mov_b64 v[44:45], 0
    v_mov_b64 v[46:47], 0
    v_mov_b64 v[48:49], 0
    v_mov_b64 v[50:51], 0
    v_mov_b64 v[52:53], 0
    v_mov_b64 v[54:55], 0
    v_mov_b64 v[92:93], 0
    v_mov_b64 v[94:95], 0
    v_mov_b64 v[96:97], 0
    v_mov_b64 v[98:99], 0
    v_mov_b64 v[100:101], 0
    v_mov_b64 v[102:103], 0
    v_mov_b64 v[104:105], 0
    v_mov_b64 v[106:107], 0
    v_mov_b64 v[108:109], 0
    v_mov_b64 v[110:111], 0
    v_mov_b64 v[112:113], 0
    v_mov_b64 v[114:115], 0
    v_mov_b64 v[116:117], 0
    v_mov_b64 v[118:119], 0
    v_mov_b64 v[120:121], 0
    v_mov_b64 v[122:123], 0
L_v:
    v_add_u32 v14, s34, v8
    v_add_u32 v15, s34, v9
    v_add_u32 v16, s34, v10
    v_add_u32 v17, s34, v11
    v_add_u32 v18, s34, v12
    s_add_u32 s31, s31, 1
    v_mov_b32 v13, s31
    s_cmp_ge_u32 s33, s32
    s_cbranch_scc1 L_v_go
    s_cmp_lg_u32 s31, 256
    s_cbranch_scc1 L_v_poll
    s_barrier
    s_branch L_v_go
L_v_poll:
    ds_read_b32 v6, v7
    s_waitcnt lgkmcnt(0)
    v_readfirstlane_b32 s33, v6
    s_lshr_b32 s29, s33, 18
    s_and_b32 s30, s33, 15
    s_or_b32 s29, s29, s30
    s_bfe_u32 s33, s33, 0xe0004
    s_sub_u32 s33, s33, s29
    s_cmp_lt_u32 s33, s32
    s_cbranch_scc1 L_v_poll
L_v_go:
    ds_read_b128 v[20:23], v18
    ds_read_b64_tr_b16 v[24:25], v14
    ds_read_b64_tr_b16 v[26:27], v14 offset:1024
    ds_read_b64_tr_b16 v[28:29], v15
    ds_read_b64_tr_b16 v[30:31], v15 offset:1024
    ds_read_b64_tr_b16 v[32:33], v16
    ds_read_b64_tr_b16 v[34:35], v16 offset:1024
    ds_read_b64_tr_b16 v[36:37], v17
    ds_read_b64_tr_b16 v[38:39], v17 offset:1024
    ds_write_b32 v3, v13 offset:16
    s_add_u32 s32, s32, 9
    s_add_u32 s34, s34, 9216
    s_cmp_eq_u32 s34, 147456
    s_cselect_b32 s34, 0, s34
    s_and_b32 s28, s31, 3
    s_waitcnt lgkmcnt(7)
    v_mfma_f32_16x16x32_bf16 v[40:43], v[20:23], v[24:27], v[40:43]
    s_waitcnt lgkmcnt(5)
    v_mfma_f32_16x16x32_bf16 v[44:47], v[20:23], v[28:31], v[44:47]
    s_waitcnt lgkmcnt(3)
    v_mfma_f32_16x16x32_bf16 v[48:51], v[20:23], v[32:35], v[48:51]
    s_waitcnt lgkmcnt(1)
    v_mfma_f32_16x16x32_bf16 v[52:55], v[20:23], v[36:39], v[52:55]
    s_cbranch_scc1 L_v
    s_and_b32 s28, s31, 63
    s_cbranch_scc1 L_fold
    s_cmp_eq_u32 s31, 256
    v_cvt_pk_bf16_f32 v24, v40, v41
    v_cvt_pk_bf16_f32 v25, v42, v43
    v_cvt_pk_bf16_f32 v26, v44, v45
    v_cvt_pk_bf16_f32 v27, v46, v47
    v_cvt_pk_bf16_f32 v28, v48, v49
    v_cvt_pk_bf16_f32 v29, v50, v51
    v_cvt_pk_bf16_f32 v30, v52, v53
    v_cvt_pk_bf16_f32 v31, v54, v55
    v_mfma_f32_16x16x16_bf16 v[76:79], v[24:25], v[66:67], 0
    v_mfma_f32_16x16x16_bf16 v[80:83], v[26:27], v[66:67], 0
    v_mfma_f32_16x16x16_bf16 v[84:87], v[28:29], v[66:67], 0
    v_mfma_f32_16x16x16_bf16 v[88:91], v[30:31], v[66:67], 0
    s_nop 6
    v_cndmask_b32 v76, v76, v84, vcc
    v_cndmask_b32 v77, v77, v85, vcc
    v_cndmask_b32 v78, v78, v86, vcc
    v_cndmask_b32 v79, v79, v87, vcc
    v_cndmask_b32 v80, v80, v88, vcc
    v_cndmask_b32 v81, v81, v89, vcc
    v_cndmask_b32 v82, v82, v90, vcc
    v_cndmask_b32 v83, v83, v91, vcc
    v_cvt_pk_bf16_f32 v72, v76, v77
    v_cvt_pk_bf16_f32 v74, v80, v81
    v_cvt_pk_bf16_f32 v73, v78, v79
    v_cvt_pk_bf16_f32 v75, v82, v83
    v_permlane16_swap_b32 v72, v74
    v_mov_b64 v[66:67], v[68:69]
    v_permlane16_swap_b32 v73, v75
    s_cbranch_scc0 L_headv
    buffer_store_dwordx4 v[72:75], v19, s[20:23], 0 offen
L_done:
    s_endpgm
.section .rodata,"a"
.p2align 6
.amdhsa_kernel standalone__low_rank_proj_linformer__sampling_kernel
  .amdhsa_next_free_vgpr 124
  .amdhsa_next_free_sgpr 80
  .amdhsa_accum_offset 124
  .amdhsa_group_segment_fixed_size 0
  .amdhsa_kernarg_size 64
  .amdhsa_user_sgpr_count 2
  .amdhsa_user_sgpr_kernarg_segment_ptr 1
  .amdhsa_system_sgpr_workgroup_id_x 1
  .amdhsa_float_denorm_mode_32 3
.end_amdhsa_kernel
```
